```python
import torch

def _softmax(x, axis=-1):
    return torch.softmax(x, dim=axis)
def _gelu(x):
    return torch.nn.functional.gelu(x, approximate="tanh")
def _silu(x):
    return torch.nn.functional.silu(x)
def _sigmoid(x):
    return torch.sigmoid(x)
def _layernorm(x, axis=-1, eps=1e-5):
    m = x.mean(dim=axis, keepdim=True)
    v = x.var(dim=axis, keepdim=True, unbiased=False)
    return (x - m) / torch.sqrt(v + eps)
def _scatter_add(tgt, idx, src, axis=0):
    return tgt.clone().index_add_(axis, idx, src)
def _segment_sum(src, seg, n):
    out = torch.zeros((n,) + src.shape[1:], dtype=src.dtype)
    return out.index_add_(0, seg, src)
def _pad(x, pw):
    flat = tuple(v for pair in reversed(pw) for v in pair)
    return torch.nn.functional.pad(x, flat)

kernel_name = 'standalone__sliding_local_strided__prompt'

def setup_inputs():

    _w = (lambda a: (lambda t: t.to(torch.bfloat16) if t.is_floating_point() else t)(torch.as_tensor(a)))
    B, H, S, D = 1, 32, 2048, 192
    return {
        "q": _w((lambda *s: torch.randn(*s, dtype=torch.bfloat16) * 0.8)(B, H, S, D)),
        "k": _w((lambda *s: torch.randn(*s, dtype=torch.bfloat16) * 0.8)(B, H, S, D)),
        "v": _w((lambda *s: torch.randn(*s, dtype=torch.bfloat16) * 0.05)(B, H, S, D)),
    }

def reference(q, k, v):
    B, H, S, D = q.shape
    W, dil = 8, 4
    scale = D ** -0.5
    pos = torch.arange(S)
    kidx = pos[:, None] - torch.arange(W)[None, :] * dil
    valid = kidx >= 0
    kidx = torch.where(valid, kidx, torch.zeros_like(kidx))
    idx = torch.reshape(kidx, (1, 1, S * W, 1))
    idx = (lambda x, n, axis: torch.repeat_interleave(x, n, dim=axis))(idx, B, 0)
    idx = (lambda x, n, axis: torch.repeat_interleave(x, n, dim=axis))(idx, H, 1)
    idx = (lambda x, n, axis: torch.repeat_interleave(x, n, dim=axis))(idx, D, 3)
    kg = torch.reshape((lambda x, i, axis: torch.take_along_dim(x, i, dim=axis))(k, idx, 2), (B, H, S, W, D))
    vg = torch.reshape((lambda x, i, axis: torch.take_along_dim(x, i, dim=axis))(v, idx, 2), (B, H, S, W, D))
    scores = torch.einsum("bhsd,bhswd->bhsw", q, kg) * scale
    mask_f = (lambda x, dt: x.to(dt))(valid, q.dtype)[None, None, :, :]
    scores = scores + (mask_f - 1.0) * 1e9
    p = _softmax(scores, axis=-1)
    return torch.einsum("bhsw,bhswd->bhsd", p, vg)
```

```asm
; @launch grid=(256,1,1) block=(256,1,1) lds=0
.amdgcn_target "amdgcn-amd-amdhsa--gfx950"
.text
.globl standalone__sliding_local_strided__prompt_kernel
.p2align 8
.type standalone__sliding_local_strided__prompt_kernel,@function
standalone__sliding_local_strided__prompt_kernel:
    s_cmp_ge_u32 s2, 256
    s_cbranch_scc1 L_end
    s_load_dwordx2 s[16:17], s[0:1], 8
    s_load_dwordx2 s[12:13], s[0:1], 0
    s_load_dwordx2 s[20:21], s[0:1], 16
    s_load_dwordx2 s[24:25], s[0:1], 24
    s_mov_b32 s18, 25165824
    s_mov_b32 s19, 0x00020000
    s_mov_b32 s14, 25165824
    s_mov_b32 s15, 0x00020000
    s_mov_b32 s22, 25165824
    s_mov_b32 s23, 0x00020000
    s_mov_b32 s26, 25165824
    s_mov_b32 s27, 0x00020000
    v_lshrrev_b32 v22, 6, v0
    v_and_b32 v20, 15, v0
    v_bfe_u32 v21, v0, 4, 2
    v_readfirstlane_b32 s40, v22
    v_and_b32 v26, 7, v0
    v_bfe_u32 v27, v0, 3, 1
    v_mul_u32_u24 v22, 1536, v26
    v_lshl_add_u32 v22, v21, 4, v22
    v_lshl_add_u32 v1, v27, 6, v22
    v_xor_b32 v2, 64, v1
    v_add_u32 v2, 12288, v2
    v_mul_u32_u24 v24, 6144, v21
    v_lshl_add_u32 v3, v20, 4, v24
    v_lshl_add_u32 v4, v20, 3, v24
    s_and_b32 s28, s2, 7
    s_lshr_b32 s29, s2, 3
    s_mul_i32 s28, s28, 32
    s_add_u32 s28, s28, s29
    s_mul_i32 s28, s28, 4
    s_add_u32 s28, s28, s40
    s_and_b32 s40, s28, 3
    s_lshr_b32 s28, s28, 2
    s_mul_i32 s40, s40, 384
    s_and_b32 s29, s28, 7
    s_mul_i32 s30, s28, 98304
    s_add_u32 s30, s30, s40
    s_cmp_eq_u32 s29, 0
    s_cselect_b32 s31, 0, 8
    s_cselect_b32 s32, 8, 0
    s_cselect_b32 s33, 4, 1
    s_sub_u32 s42, s30, 24576
    s_max_i32 s42, s42, 0
    s_add_u32 s43, s42, 3072
    s_add_u32 s44, s30, 0
    s_add_u32 s45, s30, 3072
    s_add_u32 s46, s30, 24576
    s_add_u32 s47, s30, 27648
    s_add_u32 s48, s30, 49152
    s_add_u32 s49, s30, 52224
    s_add_u32 s50, s30, 73728
    s_add_u32 s51, s30, 76800
    s_mov_b32 s39, 0x80000000
    v_mov_b32 v24, s39
    v_cmp_lt_u32 vcc, s32, v26
    s_nop 1
    v_cndmask_b32 v5, v24, v2, vcc
    v_cmp_lt_u32 vcc, s33, v21
    s_nop 1
    v_cndmask_b32 v6, v24, v3, vcc
    v_cndmask_b32 v7, v24, v4, vcc
    s_setprio 3
    s_waitcnt lgkmcnt(0)
    buffer_load_dwordx4 a[0:3], v5, s[16:19], s42 offen offset:0
    buffer_load_dwordx4 a[4:7], v5, s[16:19], s42 offen offset:128
    buffer_load_dwordx4 a[8:11], v5, s[16:19], s42 offen offset:256
    buffer_load_dwordx4 a[12:15], v1, s[16:19], s44 offen offset:0 nt
    buffer_load_dwordx4 a[16:19], v1, s[16:19], s44 offen offset:128 nt
    buffer_load_dwordx4 a[20:23], v1, s[16:19], s44 offen offset:256 nt
    buffer_load_dwordx4 a[36:39], v1, s[12:15], s44 offen offset:0 nt
    buffer_load_dwordx4 a[40:43], v1, s[12:15], s44 offen offset:128 nt
    buffer_load_dwordx4 a[44:47], v1, s[12:15], s44 offen offset:256 nt
    buffer_load_dwordx4 a[24:27], v2, s[16:19], s44 offen offset:0 nt
    buffer_load_dwordx4 a[28:31], v2, s[16:19], s44 offen offset:128 nt
    buffer_load_dwordx4 a[32:35], v2, s[16:19], s44 offen offset:256 nt
    buffer_load_dwordx4 a[48:51], v2, s[12:15], s44 offen offset:0 nt
    buffer_load_dwordx4 a[52:55], v2, s[12:15], s44 offen offset:128 nt
    buffer_load_dwordx4 a[56:59], v2, s[12:15], s44 offen offset:256 nt
    buffer_load_dwordx4 v[28:31], v6, s[20:23], s42 offen offset:0
    buffer_load_dwordx2 v[44:45], v7, s[20:23], s42 offen offset:256
    buffer_load_dwordx4 v[32:35], v6, s[20:23], s42 offen offset:1536
    buffer_load_dwordx2 v[46:47], v7, s[20:23], s42 offen offset:1792
    buffer_load_dwordx4 v[36:39], v6, s[20:23], s43 offen offset:0
    buffer_load_dwordx2 v[48:49], v7, s[20:23], s43 offen offset:256
    buffer_load_dwordx4 v[40:43], v6, s[20:23], s43 offen offset:1536
    buffer_load_dwordx2 v[50:51], v7, s[20:23], s43 offen offset:1792
    buffer_load_dwordx4 v[52:55], v3, s[20:23], s44 offen offset:0 nt
    buffer_load_dwordx2 v[68:69], v4, s[20:23], s44 offen offset:256 nt
    buffer_load_dwordx4 v[56:59], v3, s[20:23], s44 offen offset:1536 nt
    buffer_load_dwordx2 v[70:71], v4, s[20:23], s44 offen offset:1792 nt
    buffer_load_dwordx4 v[60:63], v3, s[20:23], s45 offen offset:0 nt
    buffer_load_dwordx2 v[72:73], v4, s[20:23], s45 offen offset:256 nt
    buffer_load_dwordx4 v[64:67], v3, s[20:23], s45 offen offset:1536 nt
    buffer_load_dwordx2 v[74:75], v4, s[20:23], s45 offen offset:1792 nt
    s_setprio 3
    buffer_load_dwordx4 a[60:63], v1, s[16:19], s46 offen offset:0 nt
    buffer_load_dwordx4 a[64:67], v1, s[16:19], s46 offen offset:128 nt
    buffer_load_dwordx4 a[68:71], v1, s[16:19], s46 offen offset:256 nt
    buffer_load_dwordx4 a[84:87], v1, s[12:15], s46 offen offset:0 nt
    buffer_load_dwordx4 a[88:91], v1, s[12:15], s46 offen offset:128 nt
    buffer_load_dwordx4 a[92:95], v1, s[12:15], s46 offen offset:256 nt
    buffer_load_dwordx4 a[72:75], v2, s[16:19], s46 offen offset:0 nt
    buffer_load_dwordx4 a[76:79], v2, s[16:19], s46 offen offset:128 nt
    buffer_load_dwordx4 a[80:83], v2, s[16:19], s46 offen offset:256 nt
    buffer_load_dwordx4 a[96:99], v2, s[12:15], s46 offen offset:0 nt
    buffer_load_dwordx4 a[100:103], v2, s[12:15], s46 offen offset:128 nt
    buffer_load_dwordx4 a[104:107], v2, s[12:15], s46 offen offset:256 nt
    buffer_load_dwordx4 v[76:79], v3, s[20:23], s46 offen offset:0 nt
    buffer_load_dwordx2 v[92:93], v4, s[20:23], s46 offen offset:256 nt
    buffer_load_dwordx4 v[80:83], v3, s[20:23], s46 offen offset:1536 nt
    buffer_load_dwordx2 v[94:95], v4, s[20:23], s46 offen offset:1792 nt
    buffer_load_dwordx4 v[84:87], v3, s[20:23], s47 offen offset:0 nt
    buffer_load_dwordx2 v[96:97], v4, s[20:23], s47 offen offset:256 nt
    buffer_load_dwordx4 v[88:91], v3, s[20:23], s47 offen offset:1536 nt
    buffer_load_dwordx2 v[98:99], v4, s[20:23], s47 offen offset:1792 nt
    s_mov_b32 s34, 0x05040100
    s_mov_b32 s35, 0x07060302
    s_mov_b32 s36, 0x3d93cd3a
    s_mov_b32 s37, 0x3fb8aa3b
    s_mov_b32 s38, 0xf149f2ca
    s_mov_b32 s54, 0
    s_mov_b32 s55, 0x00ff00ff
    v_mov_b32 v24, s38
    v_lshlrev_b32 v22, 2, v21
    v_sub_u32 v22, v20, v22
    v_add_u32 v23, 16, v22
    v_cndmask_b32 v22, v22, v23, s[54:55]
    v_mov_b32 v25, s31
    v_cndmask_b32 v25, 8, v25, s[54:55]
    v_subrev_u32 v23, 0, v22
    v_cmp_gt_u32 vcc, 8, v23
    s_nop 1
    v_cndmask_b32 v8, v24, 0, vcc
    v_cmp_gt_u32 vcc, v25, v23
    s_nop 1
    v_cndmask_b32 v12, v24, 0, vcc
    v_subrev_u32 v23, 1, v22
    v_cmp_gt_u32 vcc, 8, v23
    s_nop 1
    v_cndmask_b32 v9, v24, 0, vcc
    v_cmp_gt_u32 vcc, v25, v23
    s_nop 1
    v_cndmask_b32 v13, v24, 0, vcc
    v_subrev_u32 v23, 2, v22
    v_cmp_gt_u32 vcc, 8, v23
    s_nop 1
    v_cndmask_b32 v10, v24, 0, vcc
    v_cmp_gt_u32 vcc, v25, v23
    s_nop 1
    v_cndmask_b32 v14, v24, 0, vcc
    v_subrev_u32 v23, 3, v22
    v_cmp_gt_u32 vcc, 8, v23
    s_nop 1
    v_cndmask_b32 v11, v24, 0, vcc
    v_cmp_gt_u32 vcc, v25, v23
    s_nop 1
    v_cndmask_b32 v15, v24, 0, vcc
    s_waitcnt vmcnt(44)
    v_mfma_f32_16x16x32_bf16 v[20:23], a[0:3], a[36:39], 0
    v_mfma_f32_16x16x32_bf16 v[24:27], a[12:15], a[36:39], 0
    s_waitcnt vmcnt(43)
    v_mfma_f32_16x16x32_bf16 v[20:23], a[4:7], a[40:43], v[20:23]
    v_mfma_f32_16x16x32_bf16 v[24:27], a[16:19], a[40:43], v[24:27]
    s_waitcnt vmcnt(42)
    v_mfma_f32_16x16x32_bf16 v[20:23], a[8:11], a[44:47], v[20:23]
    v_mfma_f32_16x16x32_bf16 v[24:27], a[20:23], a[44:47], v[24:27]
    s_waitcnt vmcnt(38)
    v_mfma_f32_16x16x32_bf16 v[100:103], a[12:15], a[48:51], 0
    v_mfma_f32_16x16x32_bf16 v[104:107], a[24:27], a[48:51], 0
    s_waitcnt vmcnt(37)
    v_mfma_f32_16x16x32_bf16 v[100:103], a[16:19], a[52:55], v[100:103]
    v_mfma_f32_16x16x32_bf16 v[104:107], a[28:31], a[52:55], v[104:107]
    s_waitcnt vmcnt(36)
    v_mfma_f32_16x16x32_bf16 v[100:103], a[20:23], a[56:59], v[100:103]
    v_mfma_f32_16x16x32_bf16 v[104:107], a[32:35], a[56:59], v[104:107]
    v_permlane32_swap_b32 v24, v20
    v_permlane32_swap_b32 v25, v21
    v_permlane32_swap_b32 v26, v22
    v_permlane32_swap_b32 v27, v23
    s_nop 3
    v_permlane32_swap_b32 v100, v104
    v_permlane32_swap_b32 v101, v105
    v_permlane32_swap_b32 v102, v106
    v_permlane32_swap_b32 v103, v107
    v_add_f32_dpp v108, v20, v24 row_ror:8 row_mask:0x3 bank_mask:0x3
    v_add_f32_dpp v109, v21, v25 row_ror:8 row_mask:0x3 bank_mask:0x3
    v_add_f32_dpp v110, v22, v26 row_ror:8 row_mask:0x3 bank_mask:0x3
    v_add_f32_dpp v111, v23, v27 row_ror:8 row_mask:0x3 bank_mask:0x3
    v_add_f32_dpp v108, v24, v20 row_ror:8 row_mask:0xc bank_mask:0x3
    v_add_f32_dpp v109, v25, v21 row_ror:8 row_mask:0xc bank_mask:0x3
    v_add_f32_dpp v110, v26, v22 row_ror:8 row_mask:0xc bank_mask:0x3
    v_add_f32_dpp v111, v27, v23 row_ror:8 row_mask:0xc bank_mask:0x3
    v_add_f32_dpp v108, v104, v100 row_ror:8 row_mask:0x3 bank_mask:0xc
    v_add_f32_dpp v109, v105, v101 row_ror:8 row_mask:0x3 bank_mask:0xc
    v_add_f32_dpp v110, v106, v102 row_ror:8 row_mask:0x3 bank_mask:0xc
    v_add_f32_dpp v111, v107, v103 row_ror:8 row_mask:0x3 bank_mask:0xc
    v_add_f32_dpp v108, v100, v104 row_ror:8 row_mask:0xc bank_mask:0xc
    v_add_f32_dpp v109, v101, v105 row_ror:8 row_mask:0xc bank_mask:0xc
    v_add_f32_dpp v110, v102, v106 row_ror:8 row_mask:0xc bank_mask:0xc
    v_add_f32_dpp v111, v103, v107 row_ror:8 row_mask:0xc bank_mask:0xc
    v_add_f32 v108, v108, v12
    v_add_f32 v109, v109, v13
    v_add_f32 v110, v110, v14
    v_add_f32 v111, v111, v15
    v_cvt_pk_bf16_f32 v112, v108, v109
    v_cvt_pk_bf16_f32 v113, v110, v111
    v_lshlrev_b32 v108, 16, v112
    v_and_b32 v109, 0xffff0000, v112
    v_lshlrev_b32 v110, 16, v113
    v_and_b32 v111, 0xffff0000, v113
    v_mul_f32 v108, s36, v108
    v_mul_f32 v109, s36, v109
    v_mul_f32 v110, s36, v110
    v_mul_f32 v111, s36, v111
    v_cvt_pk_bf16_f32 v112, v108, v109
    v_cvt_pk_bf16_f32 v113, v110, v111
    v_lshlrev_b32 v108, 16, v112
    v_and_b32 v109, 0xffff0000, v112
    v_lshlrev_b32 v110, 16, v113
    v_and_b32 v111, 0xffff0000, v113
    v_max3_f32 v112, v108, v109, v110
    v_max_f32 v112, v112, v111
    v_mov_b32 v113, v112
    s_nop 1
    v_permlane32_swap_b32 v112, v113
    v_max_f32 v112, v112, v113
    v_mov_b32 v113, v112
    s_nop 1
    v_permlane16_swap_b32 v112, v113
    v_max_f32 v112, v112, v113
    v_sub_f32 v108, v108, v112
    v_sub_f32 v109, v109, v112
    v_sub_f32 v110, v110, v112
    v_sub_f32 v111, v111, v112
    v_mul_f32 v108, s37, v108
    v_mul_f32 v109, s37, v109
    v_mul_f32 v110, s37, v110
    v_mul_f32 v111, s37, v111
    v_exp_f32 v108, v108
    v_exp_f32 v109, v109
    v_exp_f32 v110, v110
    v_exp_f32 v111, v111
    v_add_f32 v112, v108, v109
    v_add_f32 v113, v110, v111
    v_add_f32 v112, v112, v113
    v_mov_b32 v113, v112
    s_nop 1
    v_permlane32_swap_b32 v112, v113
    v_add_f32 v112, v112, v113
    v_mov_b32 v113, v112
    s_nop 1
    v_permlane16_swap_b32 v112, v113
    v_add_f32 v112, v112, v113
    v_rcp_f32 v112, v112
    s_nop 0
    v_mul_f32 v108, v108, v112
    v_mul_f32 v109, v109, v112
    v_mul_f32 v110, v110, v112
    v_mul_f32 v111, v111, v112
    v_cvt_pk_bf16_f32 v114, v108, v109
    v_cvt_pk_bf16_f32 v115, v110, v111
    v_cndmask_b32 v18, 0, v114, s[54:55]
    v_cndmask_b32 v19, 0, v115, s[54:55]
    v_cndmask_b32 v16, v114, 0, s[54:55]
    v_cndmask_b32 v17, v115, 0, s[54:55]
    s_waitcnt vmcnt(33)
    v_perm_b32 v22, v32, v28, s34
    s_waitcnt vmcnt(29)
    v_perm_b32 v23, v40, v36, s34
    v_perm_b32 v26, v32, v28, s35
    v_perm_b32 v27, v40, v36, s35
    v_perm_b32 v102, v33, v29, s34
    v_perm_b32 v103, v41, v37, s34
    v_perm_b32 v106, v33, v29, s35
    v_perm_b32 v107, v41, v37, s35
    v_perm_b32 v110, v34, v30, s34
    v_perm_b32 v111, v42, v38, s34
    v_perm_b32 v114, v34, v30, s35
    v_perm_b32 v115, v42, v38, s35
    v_perm_b32 v118, v35, v31, s34
    v_perm_b32 v119, v43, v39, s34
    v_perm_b32 v122, v35, v31, s35
    v_perm_b32 v123, v43, v39, s35
    v_perm_b32 v126, v46, v44, s34
    s_waitcnt vmcnt(28)
    v_perm_b32 v127, v50, v48, s34
    v_perm_b32 v130, v46, v44, s35
    v_perm_b32 v131, v50, v48, s35
    v_perm_b32 v134, v47, v45, s34
    v_perm_b32 v135, v51, v49, s34
    v_perm_b32 v138, v47, v45, s35
    v_perm_b32 v139, v51, v49, s35
    s_waitcnt vmcnt(25)
    v_perm_b32 v20, v56, v52, s34
    s_waitcnt vmcnt(21)
    v_perm_b32 v21, v64, v60, s34
    v_perm_b32 v24, v56, v52, s35
    v_perm_b32 v25, v64, v60, s35
    v_perm_b32 v100, v57, v53, s34
    v_perm_b32 v101, v65, v61, s34
    v_perm_b32 v104, v57, v53, s35
    v_perm_b32 v105, v65, v61, s35
    v_perm_b32 v108, v58, v54, s34
    v_perm_b32 v109, v66, v62, s34
    v_perm_b32 v112, v58, v54, s35
    v_perm_b32 v113, v66, v62, s35
    v_perm_b32 v116, v59, v55, s34
    v_perm_b32 v117, v67, v63, s34
    v_perm_b32 v120, v59, v55, s35
    v_perm_b32 v121, v67, v63, s35
    v_perm_b32 v124, v70, v68, s34
    s_waitcnt vmcnt(20)
    v_perm_b32 v125, v74, v72, s34
    v_perm_b32 v128, v70, v68, s35
    v_perm_b32 v129, v74, v72, s35
    v_perm_b32 v132, v71, v69, s34
    v_perm_b32 v133, v75, v73, s34
    v_perm_b32 v136, v71, v69, s35
    v_perm_b32 v137, v75, v73, s35
    s_setprio 2
    buffer_load_dwordx4 a[0:3], v1, s[16:19], s48 offen offset:0 nt
    buffer_load_dwordx4 a[4:7], v1, s[16:19], s48 offen offset:128 nt
    buffer_load_dwordx4 a[8:11], v1, s[16:19], s48 offen offset:256 nt
    buffer_load_dwordx4 a[36:39], v1, s[12:15], s48 offen offset:0 nt
    buffer_load_dwordx4 a[40:43], v1, s[12:15], s48 offen offset:128 nt
    buffer_load_dwordx4 a[44:47], v1, s[12:15], s48 offen offset:256 nt
    buffer_load_dwordx4 a[12:15], v2, s[16:19], s48 offen offset:0 nt
    buffer_load_dwordx4 a[16:19], v2, s[16:19], s48 offen offset:128 nt
    buffer_load_dwordx4 a[20:23], v2, s[16:19], s48 offen offset:256 nt
    buffer_load_dwordx4 a[48:51], v2, s[12:15], s48 offen offset:0 nt
    buffer_load_dwordx4 a[52:55], v2, s[12:15], s48 offen offset:128 nt
    buffer_load_dwordx4 a[56:59], v2, s[12:15], s48 offen offset:256 nt
    buffer_load_dwordx4 v[28:31], v3, s[20:23], s48 offen offset:0 nt
    buffer_load_dwordx2 v[44:45], v4, s[20:23], s48 offen offset:256 nt
    buffer_load_dwordx4 v[32:35], v3, s[20:23], s48 offen offset:1536 nt
    buffer_load_dwordx2 v[46:47], v4, s[20:23], s48 offen offset:1792 nt
    buffer_load_dwordx4 v[36:39], v3, s[20:23], s49 offen offset:0 nt
    buffer_load_dwordx2 v[48:49], v4, s[20:23], s49 offen offset:256 nt
    buffer_load_dwordx4 v[40:43], v3, s[20:23], s49 offen offset:1536 nt
    buffer_load_dwordx2 v[50:51], v4, s[20:23], s49 offen offset:1792 nt
    v_mfma_f32_16x16x32_bf16 v[52:55], v[16:19], v[20:23], 0
    v_mfma_f32_16x16x32_bf16 v[56:59], v[16:19], v[24:27], 0
    v_mfma_f32_16x16x32_bf16 v[60:63], v[16:19], v[100:103], 0
    v_mfma_f32_16x16x32_bf16 v[64:67], v[16:19], v[104:107], 0
    v_mfma_f32_16x16x32_bf16 v[68:71], v[16:19], v[108:111], 0
    v_mfma_f32_16x16x32_bf16 v[72:75], v[16:19], v[112:115], 0
    v_mfma_f32_16x16x32_bf16 v[140:143], v[16:19], v[116:119], 0
    v_mfma_f32_16x16x32_bf16 v[144:147], v[16:19], v[120:123], 0
    v_mfma_f32_16x16x32_bf16 v[148:151], v[16:19], v[124:127], 0
    v_mfma_f32_16x16x32_bf16 v[152:155], v[16:19], v[128:131], 0
    v_mfma_f32_16x16x32_bf16 v[156:159], v[16:19], v[132:135], 0
    v_mfma_f32_16x16x32_bf16 v[160:163], v[16:19], v[136:139], 0
    v_cvt_pk_bf16_f32 v164, v52, v56
    v_cvt_pk_bf16_f32 v165, v60, v64
    v_cvt_pk_bf16_f32 v166, v68, v72
    s_nop 0
    v_cvt_pk_bf16_f32 v167, v140, v144
    v_cvt_pk_bf16_f32 v168, v53, v57
    v_cvt_pk_bf16_f32 v169, v61, v65
    v_cvt_pk_bf16_f32 v170, v69, v73
    v_cvt_pk_bf16_f32 v171, v141, v145
    v_cvt_pk_bf16_f32 v172, v54, v58
    v_cvt_pk_bf16_f32 v173, v62, v66
    v_cvt_pk_bf16_f32 v174, v70, v74
    v_cvt_pk_bf16_f32 v175, v142, v146
    v_cvt_pk_bf16_f32 v176, v55, v59
    v_cvt_pk_bf16_f32 v177, v63, v67
    v_cvt_pk_bf16_f32 v178, v71, v75
    v_cvt_pk_bf16_f32 v179, v143, v147
    v_cvt_pk_bf16_f32 v52, v148, v152
    v_cvt_pk_bf16_f32 v53, v156, v160
    v_cvt_pk_bf16_f32 v54, v149, v153
    v_cvt_pk_bf16_f32 v55, v157, v161
    v_cvt_pk_bf16_f32 v56, v150, v154
    v_cvt_pk_bf16_f32 v57, v158, v162
    v_cvt_pk_bf16_f32 v58, v151, v155
    v_cvt_pk_bf16_f32 v59, v159, v163
    s_waitcnt vmcnt(36)
    v_mfma_f32_16x16x32_bf16 v[60:63], a[24:27], a[84:87], 0
    v_mfma_f32_16x16x32_bf16 v[64:67], a[60:63], a[84:87], 0
    s_waitcnt vmcnt(35)
    v_mfma_f32_16x16x32_bf16 v[60:63], a[28:31], a[88:91], v[60:63]
    v_mfma_f32_16x16x32_bf16 v[64:67], a[64:67], a[88:91], v[64:67]
    s_waitcnt vmcnt(34)
    v_mfma_f32_16x16x32_bf16 v[60:63], a[32:35], a[92:95], v[60:63]
    v_mfma_f32_16x16x32_bf16 v[64:67], a[68:71], a[92:95], v[64:67]
    s_waitcnt vmcnt(30)
    v_mfma_f32_16x16x32_bf16 v[68:71], a[60:63], a[96:99], 0
    v_mfma_f32_16x16x32_bf16 v[72:75], a[72:75], a[96:99], 0
    s_waitcnt vmcnt(29)
    v_mfma_f32_16x16x32_bf16 v[68:71], a[64:67], a[100:103], v[68:71]
    v_mfma_f32_16x16x32_bf16 v[72:75], a[76:79], a[100:103], v[72:75]
    s_waitcnt vmcnt(28)
    v_mfma_f32_16x16x32_bf16 v[68:71], a[68:71], a[104:107], v[68:71]
    v_mfma_f32_16x16x32_bf16 v[72:75], a[80:83], a[104:107], v[72:75]
    v_permlane32_swap_b32 v64, v60
    v_permlane32_swap_b32 v65, v61
    v_permlane32_swap_b32 v66, v62
    v_permlane32_swap_b32 v67, v63
    s_nop 3
    v_permlane32_swap_b32 v68, v72
    v_permlane32_swap_b32 v69, v73
    v_permlane32_swap_b32 v70, v74
    v_permlane32_swap_b32 v71, v75
    v_add_f32_dpp v140, v60, v64 row_ror:8 row_mask:0x3 bank_mask:0x3
    v_add_f32_dpp v141, v61, v65 row_ror:8 row_mask:0x3 bank_mask:0x3
    v_add_f32_dpp v142, v62, v66 row_ror:8 row_mask:0x3 bank_mask:0x3
    v_add_f32_dpp v143, v63, v67 row_ror:8 row_mask:0x3 bank_mask:0x3
    v_add_f32_dpp v140, v64, v60 row_ror:8 row_mask:0xc bank_mask:0x3
    v_add_f32_dpp v141, v65, v61 row_ror:8 row_mask:0xc bank_mask:0x3
    v_add_f32_dpp v142, v66, v62 row_ror:8 row_mask:0xc bank_mask:0x3
    v_add_f32_dpp v143, v67, v63 row_ror:8 row_mask:0xc bank_mask:0x3
    v_add_f32_dpp v140, v72, v68 row_ror:8 row_mask:0x3 bank_mask:0xc
    v_add_f32_dpp v141, v73, v69 row_ror:8 row_mask:0x3 bank_mask:0xc
    v_add_f32_dpp v142, v74, v70 row_ror:8 row_mask:0x3 bank_mask:0xc
    v_add_f32_dpp v143, v75, v71 row_ror:8 row_mask:0x3 bank_mask:0xc
    v_add_f32_dpp v140, v68, v72 row_ror:8 row_mask:0xc bank_mask:0xc
    v_add_f32_dpp v141, v69, v73 row_ror:8 row_mask:0xc bank_mask:0xc
    v_add_f32_dpp v142, v70, v74 row_ror:8 row_mask:0xc bank_mask:0xc
    v_add_f32_dpp v143, v71, v75 row_ror:8 row_mask:0xc bank_mask:0xc
    v_add_f32 v140, v140, v8
    v_add_f32 v141, v141, v9
    v_add_f32 v142, v142, v10
    v_add_f32 v143, v143, v11
    v_cvt_pk_bf16_f32 v144, v140, v141
    v_cvt_pk_bf16_f32 v145, v142, v143
    v_lshlrev_b32 v140, 16, v144
    v_and_b32 v141, 0xffff0000, v144
    v_lshlrev_b32 v142, 16, v145
    v_and_b32 v143, 0xffff0000, v145
    v_mul_f32 v140, s36, v140
    v_mul_f32 v141, s36, v141
    v_mul_f32 v142, s36, v142
    v_mul_f32 v143, s36, v143
    v_cvt_pk_bf16_f32 v144, v140, v141
    v_cvt_pk_bf16_f32 v145, v142, v143
    v_lshlrev_b32 v140, 16, v144
    v_and_b32 v141, 0xffff0000, v144
    v_lshlrev_b32 v142, 16, v145
    v_and_b32 v143, 0xffff0000, v145
    v_max3_f32 v144, v140, v141, v142
    v_max_f32 v144, v144, v143
    v_mov_b32 v145, v144
    s_nop 1
    v_permlane32_swap_b32 v144, v145
    v_max_f32 v144, v144, v145
    v_mov_b32 v145, v144
    s_nop 1
    v_permlane16_swap_b32 v144, v145
    v_max_f32 v144, v144, v145
    v_sub_f32 v140, v140, v144
    v_sub_f32 v141, v141, v144
    v_sub_f32 v142, v142, v144
    v_sub_f32 v143, v143, v144
    v_mul_f32 v140, s37, v140
    v_mul_f32 v141, s37, v141
    v_mul_f32 v142, s37, v142
    v_mul_f32 v143, s37, v143
    v_exp_f32 v140, v140
    v_exp_f32 v141, v141
    v_exp_f32 v142, v142
    v_exp_f32 v143, v143
    v_add_f32 v144, v140, v141
    v_add_f32 v145, v142, v143
    v_add_f32 v144, v144, v145
    v_mov_b32 v145, v144
    s_nop 1
    v_permlane32_swap_b32 v144, v145
    v_add_f32 v144, v144, v145
    v_mov_b32 v145, v144
    s_nop 1
    v_permlane16_swap_b32 v144, v145
    v_add_f32 v144, v144, v145
    v_rcp_f32 v144, v144
    s_nop 0
    v_mul_f32 v140, v140, v144
    v_mul_f32 v141, v141, v144
    v_mul_f32 v142, v142, v144
    v_mul_f32 v143, v143, v144
    v_cvt_pk_bf16_f32 v146, v140, v141
    v_cvt_pk_bf16_f32 v147, v142, v143
    v_cndmask_b32 v16, 0, v146, s[54:55]
    v_cndmask_b32 v17, 0, v147, s[54:55]
    v_cndmask_b32 v18, v146, 0, s[54:55]
    v_cndmask_b32 v19, v147, 0, s[54:55]
    s_waitcnt vmcnt(25)
    v_perm_b32 v22, v80, v76, s34
    s_waitcnt vmcnt(21)
    v_perm_b32 v23, v88, v84, s34
    v_perm_b32 v26, v80, v76, s35
    v_perm_b32 v27, v88, v84, s35
    v_perm_b32 v102, v81, v77, s34
    v_perm_b32 v103, v89, v85, s34
    v_perm_b32 v106, v81, v77, s35
    v_perm_b32 v107, v89, v85, s35
    v_perm_b32 v110, v82, v78, s34
    v_perm_b32 v111, v90, v86, s34
    v_perm_b32 v114, v82, v78, s35
    v_perm_b32 v115, v90, v86, s35
    v_perm_b32 v118, v83, v79, s34
    v_perm_b32 v119, v91, v87, s34
    v_perm_b32 v122, v83, v79, s35
    v_perm_b32 v123, v91, v87, s35
    v_perm_b32 v126, v94, v92, s34
    s_waitcnt vmcnt(20)
    v_perm_b32 v127, v98, v96, s34
    v_perm_b32 v130, v94, v92, s35
    v_perm_b32 v131, v98, v96, s35
    v_perm_b32 v134, v95, v93, s34
    v_perm_b32 v135, v99, v97, s34
    v_perm_b32 v138, v95, v93, s35
    v_perm_b32 v139, v99, v97, s35
    s_setprio 1
    buffer_load_dwordx4 a[24:27], v1, s[16:19], s50 offen offset:0 nt
    buffer_load_dwordx4 a[28:31], v1, s[16:19], s50 offen offset:128 nt
    buffer_load_dwordx4 a[32:35], v1, s[16:19], s50 offen offset:256 nt
    buffer_load_dwordx4 a[84:87], v1, s[12:15], s50 offen offset:0 nt
    buffer_load_dwordx4 a[88:91], v1, s[12:15], s50 offen offset:128 nt
    buffer_load_dwordx4 a[92:95], v1, s[12:15], s50 offen offset:256 nt
    buffer_load_dwordx4 a[60:63], v2, s[16:19], s50 offen offset:0 nt
    buffer_load_dwordx4 a[64:67], v2, s[16:19], s50 offen offset:128 nt
    buffer_load_dwordx4 a[68:71], v2, s[16:19], s50 offen offset:256 nt
    buffer_load_dwordx4 a[96:99], v2, s[12:15], s50 offen offset:0 nt
    buffer_load_dwordx4 a[100:103], v2, s[12:15], s50 offen offset:128 nt
    buffer_load_dwordx4 a[104:107], v2, s[12:15], s50 offen offset:256 nt
    buffer_load_dwordx4 v[60:63], v3, s[20:23], s50 offen offset:0 nt
    buffer_load_dwordx2 v[76:77], v4, s[20:23], s50 offen offset:256 nt
    buffer_load_dwordx4 v[64:67], v3, s[20:23], s50 offen offset:1536 nt
    buffer_load_dwordx2 v[78:79], v4, s[20:23], s50 offen offset:1792 nt
    buffer_load_dwordx4 v[68:71], v3, s[20:23], s51 offen offset:0 nt
    buffer_load_dwordx2 v[80:81], v4, s[20:23], s51 offen offset:256 nt
    buffer_load_dwordx4 v[72:75], v3, s[20:23], s51 offen offset:1536 nt
    buffer_load_dwordx2 v[82:83], v4, s[20:23], s51 offen offset:1792 nt
    v_mfma_f32_16x16x32_bf16 v[84:87], v[16:19], v[20:23], 0
    v_mfma_f32_16x16x32_bf16 v[88:91], v[16:19], v[24:27], 0
    v_mfma_f32_16x16x32_bf16 v[92:95], v[16:19], v[100:103], 0
    v_mfma_f32_16x16x32_bf16 v[96:99], v[16:19], v[104:107], 0
    v_mfma_f32_16x16x32_bf16 v[140:143], v[16:19], v[108:111], 0
    v_mfma_f32_16x16x32_bf16 v[144:147], v[16:19], v[112:115], 0
    v_mfma_f32_16x16x32_bf16 v[148:151], v[16:19], v[116:119], 0
    v_mfma_f32_16x16x32_bf16 v[152:155], v[16:19], v[120:123], 0
    v_mfma_f32_16x16x32_bf16 v[156:159], v[16:19], v[124:127], 0
    v_mfma_f32_16x16x32_bf16 v[160:163], v[16:19], v[128:131], 0
    v_mfma_f32_16x16x32_bf16 v[180:183], v[16:19], v[132:135], 0
    v_mfma_f32_16x16x32_bf16 v[184:187], v[16:19], v[136:139], 0
    v_cvt_pk_bf16_f32 v188, v84, v88
    v_cvt_pk_bf16_f32 v189, v92, v96
    v_cvt_pk_bf16_f32 v190, v140, v144
    s_nop 0
    v_cvt_pk_bf16_f32 v191, v148, v152
    v_cvt_pk_bf16_f32 v192, v85, v89
    v_cvt_pk_bf16_f32 v193, v93, v97
    v_cvt_pk_bf16_f32 v194, v141, v145
    v_cvt_pk_bf16_f32 v195, v149, v153
    v_cvt_pk_bf16_f32 v196, v86, v90
    v_cvt_pk_bf16_f32 v197, v94, v98
    v_cvt_pk_bf16_f32 v198, v142, v146
    v_cvt_pk_bf16_f32 v199, v150, v154
    v_cvt_pk_bf16_f32 v200, v87, v91
    v_cvt_pk_bf16_f32 v201, v95, v99
    v_cvt_pk_bf16_f32 v202, v143, v147
    v_cvt_pk_bf16_f32 v203, v151, v155
    v_cvt_pk_bf16_f32 v84, v156, v160
    v_cvt_pk_bf16_f32 v85, v180, v184
    v_cvt_pk_bf16_f32 v86, v157, v161
    v_cvt_pk_bf16_f32 v87, v181, v185
    v_cvt_pk_bf16_f32 v88, v158, v162
    v_cvt_pk_bf16_f32 v89, v182, v186
    v_cvt_pk_bf16_f32 v90, v159, v163
    v_cvt_pk_bf16_f32 v91, v183, v187
    s_waitcnt vmcnt(36)
    v_mfma_f32_16x16x32_bf16 v[92:95], a[72:75], a[36:39], 0
    v_mfma_f32_16x16x32_bf16 v[96:99], a[0:3], a[36:39], 0
    s_waitcnt vmcnt(35)
    v_mfma_f32_16x16x32_bf16 v[92:95], a[76:79], a[40:43], v[92:95]
    v_mfma_f32_16x16x32_bf16 v[96:99], a[4:7], a[40:43], v[96:99]
    s_waitcnt vmcnt(34)
    v_mfma_f32_16x16x32_bf16 v[92:95], a[80:83], a[44:47], v[92:95]
    v_mfma_f32_16x16x32_bf16 v[96:99], a[8:11], a[44:47], v[96:99]
    s_waitcnt vmcnt(30)
    v_mfma_f32_16x16x32_bf16 v[140:143], a[0:3], a[48:51], 0
    v_mfma_f32_16x16x32_bf16 v[144:147], a[12:15], a[48:51], 0
    s_waitcnt vmcnt(29)
    v_mfma_f32_16x16x32_bf16 v[140:143], a[4:7], a[52:55], v[140:143]
    v_mfma_f32_16x16x32_bf16 v[144:147], a[16:19], a[52:55], v[144:147]
    s_waitcnt vmcnt(28)
    v_mfma_f32_16x16x32_bf16 v[140:143], a[8:11], a[56:59], v[140:143]
    v_mfma_f32_16x16x32_bf16 v[144:147], a[20:23], a[56:59], v[144:147]
    v_permlane32_swap_b32 v96, v92
    v_permlane32_swap_b32 v97, v93
    v_permlane32_swap_b32 v98, v94
    v_permlane32_swap_b32 v99, v95
    s_nop 3
    v_permlane32_swap_b32 v140, v144
    v_permlane32_swap_b32 v141, v145
    v_permlane32_swap_b32 v142, v146
    v_permlane32_swap_b32 v143, v147
    v_add_f32_dpp v148, v92, v96 row_ror:8 row_mask:0x3 bank_mask:0x3
    v_add_f32_dpp v149, v93, v97 row_ror:8 row_mask:0x3 bank_mask:0x3
    v_add_f32_dpp v150, v94, v98 row_ror:8 row_mask:0x3 bank_mask:0x3
    v_add_f32_dpp v151, v95, v99 row_ror:8 row_mask:0x3 bank_mask:0x3
    v_add_f32_dpp v148, v96, v92 row_ror:8 row_mask:0xc bank_mask:0x3
    v_add_f32_dpp v149, v97, v93 row_ror:8 row_mask:0xc bank_mask:0x3
    v_add_f32_dpp v150, v98, v94 row_ror:8 row_mask:0xc bank_mask:0x3
    v_add_f32_dpp v151, v99, v95 row_ror:8 row_mask:0xc bank_mask:0x3
    v_add_f32_dpp v148, v144, v140 row_ror:8 row_mask:0x3 bank_mask:0xc
    v_add_f32_dpp v149, v145, v141 row_ror:8 row_mask:0x3 bank_mask:0xc
    v_add_f32_dpp v150, v146, v142 row_ror:8 row_mask:0x3 bank_mask:0xc
    v_add_f32_dpp v151, v147, v143 row_ror:8 row_mask:0x3 bank_mask:0xc
    v_add_f32_dpp v148, v140, v144 row_ror:8 row_mask:0xc bank_mask:0xc
    v_add_f32_dpp v149, v141, v145 row_ror:8 row_mask:0xc bank_mask:0xc
    v_add_f32_dpp v150, v142, v146 row_ror:8 row_mask:0xc bank_mask:0xc
    v_add_f32_dpp v151, v143, v147 row_ror:8 row_mask:0xc bank_mask:0xc
    v_add_f32 v148, v148, v8
    v_add_f32 v149, v149, v9
    v_add_f32 v150, v150, v10
    v_add_f32 v151, v151, v11
    v_cvt_pk_bf16_f32 v152, v148, v149
    v_cvt_pk_bf16_f32 v153, v150, v151
    v_lshlrev_b32 v148, 16, v152
    v_and_b32 v149, 0xffff0000, v152
    v_lshlrev_b32 v150, 16, v153
    v_and_b32 v151, 0xffff0000, v153
    v_mul_f32 v148, s36, v148
    v_mul_f32 v149, s36, v149
    v_mul_f32 v150, s36, v150
    v_mul_f32 v151, s36, v151
    v_cvt_pk_bf16_f32 v152, v148, v149
    v_cvt_pk_bf16_f32 v153, v150, v151
    v_lshlrev_b32 v148, 16, v152
    v_and_b32 v149, 0xffff0000, v152
    v_lshlrev_b32 v150, 16, v153
    v_and_b32 v151, 0xffff0000, v153
    v_max3_f32 v152, v148, v149, v150
    v_max_f32 v152, v152, v151
    v_mov_b32 v153, v152
    s_nop 1
    v_permlane32_swap_b32 v152, v153
    v_max_f32 v152, v152, v153
    v_mov_b32 v153, v152
    s_nop 1
    v_permlane16_swap_b32 v152, v153
    v_max_f32 v152, v152, v153
    v_sub_f32 v148, v148, v152
    v_sub_f32 v149, v149, v152
    v_sub_f32 v150, v150, v152
    v_sub_f32 v151, v151, v152
    v_mul_f32 v148, s37, v148
    v_mul_f32 v149, s37, v149
    v_mul_f32 v150, s37, v150
    v_mul_f32 v151, s37, v151
    v_exp_f32 v148, v148
    v_exp_f32 v149, v149
    v_exp_f32 v150, v150
    v_exp_f32 v151, v151
    v_add_f32 v152, v148, v149
    v_add_f32 v153, v150, v151
    v_add_f32 v152, v152, v153
    v_mov_b32 v153, v152
    s_nop 1
    v_permlane32_swap_b32 v152, v153
    v_add_f32 v152, v152, v153
    v_mov_b32 v153, v152
    s_nop 1
    v_permlane16_swap_b32 v152, v153
    v_add_f32 v152, v152, v153
    v_rcp_f32 v152, v152
    s_nop 0
    v_mul_f32 v148, v148, v152
    v_mul_f32 v149, v149, v152
    v_mul_f32 v150, v150, v152
    v_mul_f32 v151, v151, v152
    v_cvt_pk_bf16_f32 v154, v148, v149
    v_cvt_pk_bf16_f32 v155, v150, v151
    v_cndmask_b32 v18, 0, v154, s[54:55]
    v_cndmask_b32 v19, 0, v155, s[54:55]
    v_cndmask_b32 v16, v154, 0, s[54:55]
    v_cndmask_b32 v17, v155, 0, s[54:55]
    s_waitcnt vmcnt(25)
    v_perm_b32 v20, v32, v28, s34
    s_waitcnt vmcnt(21)
    v_perm_b32 v21, v40, v36, s34
    v_perm_b32 v24, v32, v28, s35
    v_perm_b32 v25, v40, v36, s35
    v_perm_b32 v100, v33, v29, s34
    v_perm_b32 v101, v41, v37, s34
    v_perm_b32 v104, v33, v29, s35
    v_perm_b32 v105, v41, v37, s35
    v_perm_b32 v108, v34, v30, s34
    v_perm_b32 v109, v42, v38, s34
    v_perm_b32 v112, v34, v30, s35
    v_perm_b32 v113, v42, v38, s35
    v_perm_b32 v116, v35, v31, s34
    v_perm_b32 v117, v43, v39, s34
    v_perm_b32 v120, v35, v31, s35
    v_perm_b32 v121, v43, v39, s35
    v_perm_b32 v124, v46, v44, s34
    s_waitcnt vmcnt(20)
    v_perm_b32 v125, v50, v48, s34
    v_perm_b32 v128, v46, v44, s35
    v_perm_b32 v129, v50, v48, s35
    v_perm_b32 v132, v47, v45, s34
    v_perm_b32 v133, v51, v49, s34
    v_perm_b32 v136, v47, v45, s35
    v_perm_b32 v137, v51, v49, s35
    v_mfma_f32_16x16x32_bf16 v[28:31], v[16:19], v[20:23], 0
    v_mfma_f32_16x16x32_bf16 v[32:35], v[16:19], v[24:27], 0
    v_mfma_f32_16x16x32_bf16 v[36:39], v[16:19], v[100:103], 0
    v_mfma_f32_16x16x32_bf16 v[40:43], v[16:19], v[104:107], 0
    v_mfma_f32_16x16x32_bf16 v[44:47], v[16:19], v[108:111], 0
    v_mfma_f32_16x16x32_bf16 v[48:51], v[16:19], v[112:115], 0
    v_mfma_f32_16x16x32_bf16 v[92:95], v[16:19], v[116:119], 0
    v_mfma_f32_16x16x32_bf16 v[96:99], v[16:19], v[120:123], 0
    v_mfma_f32_16x16x32_bf16 v[140:143], v[16:19], v[124:127], 0
    v_mfma_f32_16x16x32_bf16 v[144:147], v[16:19], v[128:131], 0
    v_mfma_f32_16x16x32_bf16 v[148:151], v[16:19], v[132:135], 0
    v_mfma_f32_16x16x32_bf16 v[152:155], v[16:19], v[136:139], 0
    v_cvt_pk_bf16_f32 v156, v28, v32
    v_cvt_pk_bf16_f32 v157, v36, v40
    v_cvt_pk_bf16_f32 v158, v44, v48
    s_nop 0
    v_cvt_pk_bf16_f32 v159, v92, v96
    v_cvt_pk_bf16_f32 v160, v29, v33
    v_cvt_pk_bf16_f32 v161, v37, v41
    v_cvt_pk_bf16_f32 v162, v45, v49
    v_cvt_pk_bf16_f32 v163, v93, v97
    v_cvt_pk_bf16_f32 v180, v30, v34
    v_cvt_pk_bf16_f32 v181, v38, v42
    v_cvt_pk_bf16_f32 v182, v46, v50
    v_cvt_pk_bf16_f32 v183, v94, v98
    v_cvt_pk_bf16_f32 v184, v31, v35
    v_cvt_pk_bf16_f32 v185, v39, v43
    v_cvt_pk_bf16_f32 v186, v47, v51
    v_cvt_pk_bf16_f32 v187, v95, v99
    v_cvt_pk_bf16_f32 v28, v140, v144
    v_cvt_pk_bf16_f32 v29, v148, v152
    v_cvt_pk_bf16_f32 v30, v141, v145
    v_cvt_pk_bf16_f32 v31, v149, v153
    v_cvt_pk_bf16_f32 v32, v142, v146
    v_cvt_pk_bf16_f32 v33, v150, v154
    v_cvt_pk_bf16_f32 v34, v143, v147
    v_cvt_pk_bf16_f32 v35, v151, v155
    s_waitcnt vmcnt(16)
    v_mfma_f32_16x16x32_bf16 v[36:39], a[12:15], a[84:87], 0
    v_mfma_f32_16x16x32_bf16 v[40:43], a[24:27], a[84:87], 0
    s_waitcnt vmcnt(15)
    v_mfma_f32_16x16x32_bf16 v[36:39], a[16:19], a[88:91], v[36:39]
    v_mfma_f32_16x16x32_bf16 v[40:43], a[28:31], a[88:91], v[40:43]
    s_waitcnt vmcnt(14)
    v_mfma_f32_16x16x32_bf16 v[36:39], a[20:23], a[92:95], v[36:39]
    v_mfma_f32_16x16x32_bf16 v[40:43], a[32:35], a[92:95], v[40:43]
    s_waitcnt vmcnt(10)
    v_mfma_f32_16x16x32_bf16 v[44:47], a[24:27], a[96:99], 0
    v_mfma_f32_16x16x32_bf16 v[48:51], a[60:63], a[96:99], 0
    s_waitcnt vmcnt(9)
    v_mfma_f32_16x16x32_bf16 v[44:47], a[28:31], a[100:103], v[44:47]
    v_mfma_f32_16x16x32_bf16 v[48:51], a[64:67], a[100:103], v[48:51]
    s_waitcnt vmcnt(8)
    v_mfma_f32_16x16x32_bf16 v[44:47], a[32:35], a[104:107], v[44:47]
    v_mfma_f32_16x16x32_bf16 v[48:51], a[68:71], a[104:107], v[48:51]
    v_permlane32_swap_b32 v40, v36
    v_permlane32_swap_b32 v41, v37
    v_permlane32_swap_b32 v42, v38
    v_permlane32_swap_b32 v43, v39
    s_nop 3
    v_permlane32_swap_b32 v44, v48
    v_permlane32_swap_b32 v45, v49
    v_permlane32_swap_b32 v46, v50
    v_permlane32_swap_b32 v47, v51
    v_add_f32_dpp v92, v36, v40 row_ror:8 row_mask:0x3 bank_mask:0x3
    v_add_f32_dpp v93, v37, v41 row_ror:8 row_mask:0x3 bank_mask:0x3
    v_add_f32_dpp v94, v38, v42 row_ror:8 row_mask:0x3 bank_mask:0x3
    v_add_f32_dpp v95, v39, v43 row_ror:8 row_mask:0x3 bank_mask:0x3
    v_add_f32_dpp v92, v40, v36 row_ror:8 row_mask:0xc bank_mask:0x3
    v_add_f32_dpp v93, v41, v37 row_ror:8 row_mask:0xc bank_mask:0x3
    v_add_f32_dpp v94, v42, v38 row_ror:8 row_mask:0xc bank_mask:0x3
    v_add_f32_dpp v95, v43, v39 row_ror:8 row_mask:0xc bank_mask:0x3
    v_add_f32_dpp v92, v48, v44 row_ror:8 row_mask:0x3 bank_mask:0xc
    v_add_f32_dpp v93, v49, v45 row_ror:8 row_mask:0x3 bank_mask:0xc
    v_add_f32_dpp v94, v50, v46 row_ror:8 row_mask:0x3 bank_mask:0xc
    v_add_f32_dpp v95, v51, v47 row_ror:8 row_mask:0x3 bank_mask:0xc
    v_add_f32_dpp v92, v44, v48 row_ror:8 row_mask:0xc bank_mask:0xc
    v_add_f32_dpp v93, v45, v49 row_ror:8 row_mask:0xc bank_mask:0xc
    v_add_f32_dpp v94, v46, v50 row_ror:8 row_mask:0xc bank_mask:0xc
    v_add_f32_dpp v95, v47, v51 row_ror:8 row_mask:0xc bank_mask:0xc
    v_add_f32 v92, v92, v8
    v_add_f32 v93, v93, v9
    v_add_f32 v94, v94, v10
    v_add_f32 v95, v95, v11
    v_cvt_pk_bf16_f32 v96, v92, v93
    v_cvt_pk_bf16_f32 v97, v94, v95
    v_lshlrev_b32 v92, 16, v96
    v_and_b32 v93, 0xffff0000, v96
    v_lshlrev_b32 v94, 16, v97
    v_and_b32 v95, 0xffff0000, v97
    v_mul_f32 v92, s36, v92
    v_mul_f32 v93, s36, v93
    v_mul_f32 v94, s36, v94
    v_mul_f32 v95, s36, v95
    v_cvt_pk_bf16_f32 v96, v92, v93
    v_cvt_pk_bf16_f32 v97, v94, v95
    v_lshlrev_b32 v92, 16, v96
    v_and_b32 v93, 0xffff0000, v96
    v_lshlrev_b32 v94, 16, v97
    v_and_b32 v95, 0xffff0000, v97
    v_max3_f32 v96, v92, v93, v94
    v_max_f32 v96, v96, v95
    v_mov_b32 v97, v96
    s_nop 1
    v_permlane32_swap_b32 v96, v97
    v_max_f32 v96, v96, v97
    v_mov_b32 v97, v96
    s_nop 1
    v_permlane16_swap_b32 v96, v97
    v_max_f32 v96, v96, v97
    v_sub_f32 v92, v92, v96
    v_sub_f32 v93, v93, v96
    v_sub_f32 v94, v94, v96
    v_sub_f32 v95, v95, v96
    v_mul_f32 v92, s37, v92
    v_mul_f32 v93, s37, v93
    v_mul_f32 v94, s37, v94
    v_mul_f32 v95, s37, v95
    v_exp_f32 v92, v92
    v_exp_f32 v93, v93
    v_exp_f32 v94, v94
    v_exp_f32 v95, v95
    v_add_f32 v96, v92, v93
    v_add_f32 v97, v94, v95
    v_add_f32 v96, v96, v97
    v_mov_b32 v97, v96
    s_nop 1
    v_permlane32_swap_b32 v96, v97
    v_add_f32 v96, v96, v97
    v_mov_b32 v97, v96
    s_nop 1
    v_permlane16_swap_b32 v96, v97
    v_add_f32 v96, v96, v97
    v_rcp_f32 v96, v96
    s_nop 0
    v_mul_f32 v92, v92, v96
    v_mul_f32 v93, v93, v96
    v_mul_f32 v94, v94, v96
    v_mul_f32 v95, v95, v96
    v_cvt_pk_bf16_f32 v98, v92, v93
    v_cvt_pk_bf16_f32 v99, v94, v95
    v_cndmask_b32 v16, 0, v98, s[54:55]
    v_cndmask_b32 v17, 0, v99, s[54:55]
    v_cndmask_b32 v18, v98, 0, s[54:55]
    v_cndmask_b32 v19, v99, 0, s[54:55]
    s_waitcnt vmcnt(5)
    v_perm_b32 v22, v64, v60, s34
    s_waitcnt vmcnt(1)
    v_perm_b32 v23, v72, v68, s34
    v_perm_b32 v26, v64, v60, s35
    v_perm_b32 v27, v72, v68, s35
    v_perm_b32 v102, v65, v61, s34
    v_perm_b32 v103, v73, v69, s34
    v_perm_b32 v106, v65, v61, s35
    v_perm_b32 v107, v73, v69, s35
    v_perm_b32 v110, v66, v62, s34
    v_perm_b32 v111, v74, v70, s34
    v_perm_b32 v114, v66, v62, s35
    v_perm_b32 v115, v74, v70, s35
    v_perm_b32 v118, v67, v63, s34
    v_perm_b32 v119, v75, v71, s34
    v_perm_b32 v122, v67, v63, s35
    v_perm_b32 v123, v75, v71, s35
    v_perm_b32 v126, v78, v76, s34
    s_waitcnt vmcnt(0)
    v_perm_b32 v127, v82, v80, s34
    v_perm_b32 v130, v78, v76, s35
    v_perm_b32 v131, v82, v80, s35
    v_perm_b32 v134, v79, v77, s34
    v_perm_b32 v135, v83, v81, s34
    v_perm_b32 v138, v79, v77, s35
    v_perm_b32 v139, v83, v81, s35
    v_mfma_f32_16x16x32_bf16 v[36:39], v[16:19], v[20:23], 0
    v_mfma_f32_16x16x32_bf16 v[40:43], v[16:19], v[24:27], 0
    v_mfma_f32_16x16x32_bf16 v[44:47], v[16:19], v[100:103], 0
    v_mfma_f32_16x16x32_bf16 v[48:51], v[16:19], v[104:107], 0
    v_mfma_f32_16x16x32_bf16 v[60:63], v[16:19], v[108:111], 0
    v_mfma_f32_16x16x32_bf16 v[64:67], v[16:19], v[112:115], 0
    v_mfma_f32_16x16x32_bf16 v[68:71], v[16:19], v[116:119], 0
    v_mfma_f32_16x16x32_bf16 v[72:75], v[16:19], v[120:123], 0
    v_mfma_f32_16x16x32_bf16 v[76:79], v[16:19], v[124:127], 0
    v_mfma_f32_16x16x32_bf16 v[80:83], v[16:19], v[128:131], 0
    v_mfma_f32_16x16x32_bf16 v[92:95], v[16:19], v[132:135], 0
    v_mfma_f32_16x16x32_bf16 v[96:99], v[16:19], v[136:139], 0
    v_cvt_pk_bf16_f32 v20, v36, v40
    v_cvt_pk_bf16_f32 v21, v44, v48
    v_cvt_pk_bf16_f32 v22, v60, v64
    s_nop 0
    v_cvt_pk_bf16_f32 v23, v68, v72
    v_cvt_pk_bf16_f32 v24, v37, v41
    v_cvt_pk_bf16_f32 v25, v45, v49
    v_cvt_pk_bf16_f32 v26, v61, v65
    v_cvt_pk_bf16_f32 v27, v69, v73
    v_cvt_pk_bf16_f32 v100, v38, v42
    v_cvt_pk_bf16_f32 v101, v46, v50
    v_cvt_pk_bf16_f32 v102, v62, v66
    v_cvt_pk_bf16_f32 v103, v70, v74
    v_cvt_pk_bf16_f32 v104, v39, v43
    v_cvt_pk_bf16_f32 v105, v47, v51
    v_cvt_pk_bf16_f32 v106, v63, v67
    v_cvt_pk_bf16_f32 v107, v71, v75
    v_cvt_pk_bf16_f32 v36, v76, v80
    v_cvt_pk_bf16_f32 v37, v92, v96
    v_cvt_pk_bf16_f32 v38, v77, v81
    v_cvt_pk_bf16_f32 v39, v93, v97
    v_cvt_pk_bf16_f32 v40, v78, v82
    v_cvt_pk_bf16_f32 v41, v94, v98
    v_cvt_pk_bf16_f32 v42, v79, v83
    v_cvt_pk_bf16_f32 v43, v95, v99
    s_setprio 0
    buffer_store_dwordx4 v[164:167], v3, s[24:27], s44 offen offset:0 sc1 nt
    buffer_store_dwordx4 v[168:171], v3, s[24:27], s44 offen offset:1536 sc1 nt
    buffer_store_dwordx4 v[172:175], v3, s[24:27], s45 offen offset:0 sc1 nt
    buffer_store_dwordx4 v[176:179], v3, s[24:27], s45 offen offset:1536 sc1 nt
    buffer_store_dwordx2 v[52:53], v4, s[24:27], s44 offen offset:256 sc1 nt
    buffer_store_dwordx2 v[54:55], v4, s[24:27], s44 offen offset:1792 sc1 nt
    buffer_store_dwordx2 v[56:57], v4, s[24:27], s45 offen offset:256 sc1 nt
    buffer_store_dwordx2 v[58:59], v4, s[24:27], s45 offen offset:1792 sc1 nt
    buffer_store_dwordx4 v[188:191], v3, s[24:27], s46 offen offset:0 sc1 nt
    buffer_store_dwordx4 v[192:195], v3, s[24:27], s46 offen offset:1536 sc1 nt
    buffer_store_dwordx4 v[196:199], v3, s[24:27], s47 offen offset:0 sc1 nt
    buffer_store_dwordx4 v[200:203], v3, s[24:27], s47 offen offset:1536 sc1 nt
    buffer_store_dwordx2 v[84:85], v4, s[24:27], s46 offen offset:256 sc1 nt
    buffer_store_dwordx2 v[86:87], v4, s[24:27], s46 offen offset:1792 sc1 nt
    buffer_store_dwordx2 v[88:89], v4, s[24:27], s47 offen offset:256 sc1 nt
    buffer_store_dwordx2 v[90:91], v4, s[24:27], s47 offen offset:1792 sc1 nt
    buffer_store_dwordx4 v[156:159], v3, s[24:27], s48 offen offset:0 sc1
    buffer_store_dwordx4 v[160:163], v3, s[24:27], s48 offen offset:1536 sc1
    buffer_store_dwordx4 v[180:183], v3, s[24:27], s49 offen offset:0 sc1
    buffer_store_dwordx4 v[184:187], v3, s[24:27], s49 offen offset:1536 sc1
    buffer_store_dwordx2 v[28:29], v4, s[24:27], s48 offen offset:256 sc1
    buffer_store_dwordx2 v[30:31], v4, s[24:27], s48 offen offset:1792 sc1
    buffer_store_dwordx2 v[32:33], v4, s[24:27], s49 offen offset:256 sc1
    buffer_store_dwordx2 v[34:35], v4, s[24:27], s49 offen offset:1792 sc1
    buffer_store_dwordx4 v[20:23], v3, s[24:27], s50 offen offset:0 sc1
    buffer_store_dwordx4 v[24:27], v3, s[24:27], s50 offen offset:1536 sc1
    buffer_store_dwordx4 v[100:103], v3, s[24:27], s51 offen offset:0 sc1
    buffer_store_dwordx4 v[104:107], v3, s[24:27], s51 offen offset:1536 sc1
    buffer_store_dwordx2 v[36:37], v4, s[24:27], s50 offen offset:256 sc1
    buffer_store_dwordx2 v[38:39], v4, s[24:27], s50 offen offset:1792 sc1
    buffer_store_dwordx2 v[40:41], v4, s[24:27], s51 offen offset:256 sc1
    buffer_store_dwordx2 v[42:43], v4, s[24:27], s51 offen offset:1792 sc1
L_end:
    s_endpgm
.section .rodata,"a"
.p2align 6
.amdhsa_kernel standalone__sliding_local_strided__prompt_kernel
  .amdhsa_next_free_vgpr 312
  .amdhsa_next_free_sgpr 56
  .amdhsa_accum_offset 204
  .amdhsa_group_segment_fixed_size 0
  .amdhsa_kernarg_size 48
  .amdhsa_user_sgpr_count 2
  .amdhsa_user_sgpr_kernarg_segment_ptr 1
  .amdhsa_system_sgpr_workgroup_id_x 1
.end_amdhsa_kernel
```
